```python
import torch

def _softmax(x, axis=-1):
    return torch.softmax(x, dim=axis)
def _gelu(x):
    return torch.nn.functional.gelu(x, approximate="tanh")
def _silu(x):
    return torch.nn.functional.silu(x)
def _sigmoid(x):
    return torch.sigmoid(x)
def _layernorm(x, axis=-1, eps=1e-5):
    m = x.mean(dim=axis, keepdim=True)
    v = x.var(dim=axis, keepdim=True, unbiased=False)
    return (x - m) / torch.sqrt(v + eps)
def _scatter_add(tgt, idx, src, axis=0):
    return tgt.clone().index_add_(axis, idx, src)
def _segment_sum(src, seg, n):
    out = torch.zeros((n,) + src.shape[1:], dtype=src.dtype)
    return out.index_add_(0, seg, src)
def _pad(x, pw):
    flat = tuple(v for pair in reversed(pw) for v in pair)
    return torch.nn.functional.pad(x, flat)

kernel_name = 'standalone__deep_cross_wide_deep__recsys'

def setup_inputs():

    _w = (lambda a: (lambda t: t.to(torch.bfloat16) if t.is_floating_point() else t)(torch.as_tensor(a)))
    B, F, D = 16384, 100, 32
    V, Nd = min(1000, 100000), 13
    Din = F * D
    H = 4 * D
    return {
        "idx": _w((lambda lo, hi, *s: torch.randint(lo, hi, s))(0, V, B, F).to(torch.int64)),
        "table": _w((lambda *s: torch.randn(*s, dtype=torch.bfloat16) * 1.6)(V, D) * 0.05),
        "x_wide": _w((lambda *s: torch.randn(*s, dtype=torch.bfloat16) * 1.6)(B, Nd)),
        "w_wide": _w((lambda *s: torch.randn(*s, dtype=torch.bfloat16) * 1.6)(Nd) * 0.05),
        "b_wide": _w((lambda *s: torch.randn(*s, dtype=torch.bfloat16) * 1.6)(1) * 0.01),
        "W1": _w((lambda *s: torch.randn(*s, dtype=torch.bfloat16) * 1.6)(Din, H) * (2.0 / Din) ** 0.5),
        "b1": _w((lambda *s: torch.randn(*s, dtype=torch.bfloat16) * 1.6)(H) * 0.01),
        "W2": _w((lambda *s: torch.randn(*s, dtype=torch.bfloat16) * 1.6)(H) * (1.0 / H) ** 0.5),
        "b2": _w((lambda *s: torch.randn(*s, dtype=torch.bfloat16) * 1.6)(1) * 0.01),
    }

def reference(idx, table, x_wide, w_wide, b_wide, W1, b1, W2, b2):
    emb = table[idx]
    deep_in = emb.reshape(emb.shape[0], -1)
    h = deep_in @ W1 + b1
    h = h * (lambda x, dt: x.to(dt))(h > 0, h.dtype)
    deep_logit = h @ W2 + b2
    wide_logit = x_wide @ w_wide + b_wide
    return _sigmoid(wide_logit + deep_logit)
```

```asm
; @launch grid=(256,1,1) block=(256,1,1) lds=163552
.amdgcn_target "amdgcn-amd-amdhsa--gfx950"
.text
.globl standalone__deep_cross_wide_deep__recsys_kernel
.p2align 8
.type standalone__deep_cross_wide_deep__recsys_kernel,@function
standalone__deep_cross_wide_deep__recsys_kernel:
    s_cmp_ge_u32 s2, 256
    s_cbranch_scc1 L_end
    s_load_dwordx16 s[4:19], s[0:1], 0
    s_load_dwordx4 s[20:23], s[0:1], 64
    v_lshrrev_b32 v1, 6, v0
    v_and_b32 v0, 63, v0
    v_readfirstlane_b32 s52, v1
    v_lshlrev_b32 v7, 4, v0
    s_mov_b32 s30, 25600
    s_mov_b32 s31, 0x20000
    s_mov_b32 s34, 64000
    s_mov_b32 s35, 0x20000
    s_mov_b32 s38, 416
    s_mov_b32 s39, 0x20000
    s_mov_b32 s42, 256
    s_mov_b32 s43, 0x20000
    s_mov_b32 s46, 256
    s_mov_b32 s47, 0x20000
    s_lshl_b32 s74, s2, 2
    s_add_u32 s74, s74, s52
    s_mul_i32 s80, s74, 416
    s_lshl_b32 s62, s74, 5
    s_mul_i32 s75, s2, 25600
    s_lshl_b32 s81, s52, 11
    s_add_u32 s81, s81, 140000
    s_mov_b32 m0, s81
    v_and_b32 v11, 15, v0
    v_lshrrev_b32 v9, 4, v0
    v_lshlrev_b32 v1, 4, v11
    v_lshl_add_u32 v1, v9, 11, v1
    v_mul_u32_u24 v2, 16416, v9
    v_and_b32 v10, 3, v0
    v_mul_u32_u24 v10, 16416, v10
    v_lshrrev_b32 v8, 2, v0
    v_lshl_add_u32 v10, v8, 4, v10
    s_mov_b32 s53, 0x05040100
    s_mov_b32 s54, 0x07060302
    s_lshr_b32 s63, s2, 3
    s_and_b32 s84, s63, 3
    s_mul_i32 s84, s84, 6144
    s_mul_i32 s83, s52, 21504
    s_mul_i32 s74, s63, 43
    s_lshr_b32 s74, s74, 8
    s_mul_i32 s74, s74, 6
    s_sub_u32 s63, s63, s74
    s_lshl_b32 s63, s63, 17
    s_lshl_b32 s74, s52, 15
    s_add_u32 s56, s63, s74
    s_add_u32 s61, s52, 96
    s_lshl_b32 s61, s61, 13
    s_mov_b32 s55, 0
    s_mov_b32 s26, 819200
    s_mov_b32 s27, 0x20000
    s_mov_b32 s50, 32768
    s_mov_b32 s51, 0x20000
    s_mov_b32 s57, s56
    s_add_u32 s58, s56, 8192
    s_add_u32 s59, s56, 16384
    s_add_u32 s60, s56, 24576
    v_mul_u32_u24 v5, 400, v11
    s_xor_b32 s63, s52, 1
    s_mul_i32 s74, s63, 3072
    s_add_u32 s74, s74, 65248
    v_add_u32 v13, s74, v7
    s_mul_i32 s74, s63, 6400
    s_add_u32 s74, s74, 114400
    v_add_u32 v41, s74, v5
    v_add_u32 v30, 49152, v13
    s_xor_b32 s63, s52, 2
    s_mul_i32 s74, s63, 3072
    s_add_u32 s74, s74, 66272
    v_add_u32 v14, s74, v7
    s_mul_i32 s74, s63, 6400
    s_add_u32 s74, s74, 114400
    v_add_u32 v42, s74, v5
    v_add_u32 v31, 49152, v14
    s_xor_b32 s63, s52, 3
    s_mul_i32 s74, s63, 3072
    s_add_u32 s74, s74, 67296
    v_add_u32 v15, s74, v7
    s_mul_i32 s74, s63, 6400
    s_add_u32 s74, s74, 114400
    v_add_u32 v43, s74, v5
    v_add_u32 v32, 49152, v15
    s_mul_i32 s63, s52, 3072
    s_add_u32 s63, s63, 65248
    v_add_u32 v16, s63, v7
    v_add_u32 v33, 49152, v16
    s_mul_i32 s74, s52, 6400
    s_add_u32 s74, s74, 114400
    v_add_u32 v40, s74, v5
    v_lshlrev_b32 v17, 6, v9
    v_add_u32 v17, s81, v17
    v_mul_u32_u24 v3, 26, v11
    v_and_b32 v4, 2, v3
    v_and_b32 v3, 0xfffc, v3
    v_add_u32 v3, s81, v3
    v_add_u32 v3, 1024, v3
    v_lshlrev_b32 v18, 1, v11
    s_lshr_b32 s78, s56, 11
    s_lshl_b32 s63, s52, 2
    s_add_u32 s63, s63, 384
    v_add_u32 v44, s78, v40
    v_add_u32 v24, s63, v40
    v_add_u32 v45, s78, v41
    v_add_u32 v25, s63, v41
    v_add_u32 v46, s78, v42
    v_add_u32 v26, s63, v42
    v_add_u32 v47, s78, v43
    v_add_u32 v27, s63, v43
    v_accvgpr_write_b32 a0, 0
    v_accvgpr_write_b32 a1, 0
    v_accvgpr_write_b32 a2, 0
    v_accvgpr_write_b32 a3, 0
    v_accvgpr_write_b32 a4, 0
    v_accvgpr_write_b32 a5, 0
    v_accvgpr_write_b32 a6, 0
    v_accvgpr_write_b32 a7, 0
    s_mov_b32 s85, s84
    s_add_u32 s63, s83, s85
    s_mov_b32 s82, 0
    s_mov_b32 exec_hi, 0
    s_waitcnt lgkmcnt(0)
    s_mov_b32 s40, s16
    s_mov_b32 s41, s17
    buffer_load_dwordx4 v7, s[40:43], 0 offen lds
    s_add_u32 m0, s81, 512
    s_mov_b32 s44, s18
    s_mov_b32 s45, s19
    buffer_load_dwordx4 v7, s[44:47], 0 offen lds
    s_add_u32 m0, s81, 1024
    s_add_u32 s36, s8, s80
    s_addc_u32 s37, s9, 0
    buffer_load_dwordx4 v7, s[36:39], 0 offen lds
    s_mov_b32 exec_hi, -1
    s_mov_b32 s32, s6
    s_mov_b32 s33, s7
    s_cmp_eq_u32 s52, 3
    s_cbranch_scc1 L_idxwave
    buffer_load_dwordx4 a[128:131], v7, s[32:35], s63 offen offset:0
    s_mov_b32 s24, s14
    s_mov_b32 s25, s15
    s_mov_b32 s48, s22
    s_mov_b32 s49, s23
    s_load_dwordx8 s[64:71], s[10:11], 0
    s_load_dword s72, s[12:13], 0
    s_load_dword s73, s[20:21], 0
    buffer_load_dwordx4 a[132:135], v7, s[32:35], s63 offen offset:1024
    v_accvgpr_write_b32 a8, 0
    v_accvgpr_write_b32 a9, 0
    v_accvgpr_write_b32 a10, 0
    v_accvgpr_write_b32 a11, 0
    v_accvgpr_write_b32 a12, 0
    v_accvgpr_write_b32 a13, 0
    v_accvgpr_write_b32 a14, 0
    buffer_load_dwordx4 a[136:139], v7, s[32:35], s63 offen offset:2048
    s_add_u32 s85, s85, 3072
    s_cmp_eq_u32 s85, 21504
    s_cselect_b32 s85, 0, s85
    s_add_u32 s63, s83, s85
    buffer_load_dwordx4 a[140:143], v7, s[32:35], s63 offen offset:0
    v_accvgpr_write_b32 a15, 0
    v_accvgpr_write_b32 a16, 0
    v_accvgpr_write_b32 a17, 0
    v_accvgpr_write_b32 a18, 0
    v_accvgpr_write_b32 a19, 0
    v_accvgpr_write_b32 a20, 0
    v_accvgpr_write_b32 a21, 0
    buffer_load_dwordx4 a[144:147], v7, s[32:35], s63 offen offset:1024
    v_accvgpr_write_b32 a22, 0
    v_accvgpr_write_b32 a23, 0
    v_accvgpr_write_b32 a24, 0
    v_accvgpr_write_b32 a25, 0
    v_accvgpr_write_b32 a26, 0
    v_accvgpr_write_b32 a27, 0
    v_accvgpr_write_b32 a28, 0
    buffer_load_dwordx4 a[148:151], v7, s[32:35], s63 offen offset:2048
    s_add_u32 s85, s85, 3072
    s_cmp_eq_u32 s85, 21504
    s_cselect_b32 s85, 0, s85
    s_add_u32 s63, s83, s85
    buffer_load_dwordx4 a[152:155], v7, s[32:35], s63 offen offset:0
    v_accvgpr_write_b32 a29, 0
    v_accvgpr_write_b32 a30, 0
    v_accvgpr_write_b32 a31, 0
    v_accvgpr_write_b32 a32, 0
    v_accvgpr_write_b32 a33, 0
    v_accvgpr_write_b32 a34, 0
    v_accvgpr_write_b32 a35, 0
    buffer_load_dwordx4 a[156:159], v7, s[32:35], s63 offen offset:1024
    v_accvgpr_write_b32 a36, 0
    v_accvgpr_write_b32 a37, 0
    v_accvgpr_write_b32 a38, 0
    v_accvgpr_write_b32 a39, 0
    v_accvgpr_write_b32 a40, 0
    v_accvgpr_write_b32 a41, 0
    v_accvgpr_write_b32 a42, 0
    buffer_load_dwordx4 a[160:163], v7, s[32:35], s63 offen offset:2048
    s_add_u32 s85, s85, 3072
    s_cmp_eq_u32 s85, 21504
    s_cselect_b32 s85, 0, s85
    s_add_u32 s63, s83, s85
    buffer_load_dwordx4 a[164:167], v7, s[32:35], s63 offen offset:0
    v_accvgpr_write_b32 a43, 0
    v_accvgpr_write_b32 a44, 0
    v_accvgpr_write_b32 a45, 0
    v_accvgpr_write_b32 a46, 0
    v_accvgpr_write_b32 a47, 0
    v_accvgpr_write_b32 a48, 0
    v_accvgpr_write_b32 a49, 0
    buffer_load_dwordx4 a[168:171], v7, s[32:35], s63 offen offset:1024
    v_accvgpr_write_b32 a50, 0
    v_accvgpr_write_b32 a51, 0
    v_accvgpr_write_b32 a52, 0
    v_accvgpr_write_b32 a53, 0
    v_accvgpr_write_b32 a54, 0
    v_accvgpr_write_b32 a55, 0
    v_accvgpr_write_b32 a56, 0
    buffer_load_dwordx4 a[172:175], v7, s[32:35], s63 offen offset:2048
    s_add_u32 s85, s85, 3072
    s_cmp_eq_u32 s85, 21504
    s_cselect_b32 s85, 0, s85
    s_add_u32 s63, s83, s85
    buffer_load_dwordx4 a[176:179], v7, s[32:35], s63 offen offset:0
    v_accvgpr_write_b32 a57, 0
    v_accvgpr_write_b32 a58, 0
    v_accvgpr_write_b32 a59, 0
    v_accvgpr_write_b32 a60, 0
    v_accvgpr_write_b32 a61, 0
    v_accvgpr_write_b32 a62, 0
    v_accvgpr_write_b32 a63, 0
    buffer_load_dwordx4 a[180:183], v7, s[32:35], s63 offen offset:1024
    v_accvgpr_write_b32 a64, 0
    v_accvgpr_write_b32 a65, 0
    v_accvgpr_write_b32 a66, 0
    v_accvgpr_write_b32 a67, 0
    v_accvgpr_write_b32 a68, 0
    v_accvgpr_write_b32 a69, 0
    v_accvgpr_write_b32 a70, 0
    buffer_load_dwordx4 a[184:187], v7, s[32:35], s63 offen offset:2048
    s_add_u32 s85, s85, 3072
    s_cmp_eq_u32 s85, 21504
    s_cselect_b32 s85, 0, s85
    s_add_u32 s63, s83, s85
    buffer_load_dwordx4 a[188:191], v7, s[32:35], s63 offen offset:0
    v_accvgpr_write_b32 a71, 0
    v_accvgpr_write_b32 a72, 0
    v_accvgpr_write_b32 a73, 0
    v_accvgpr_write_b32 a74, 0
    v_accvgpr_write_b32 a75, 0
    v_accvgpr_write_b32 a76, 0
    v_accvgpr_write_b32 a77, 0
    buffer_load_dwordx4 a[192:195], v7, s[32:35], s63 offen offset:1024
    v_accvgpr_write_b32 a78, 0
    v_accvgpr_write_b32 a79, 0
    v_accvgpr_write_b32 a80, 0
    v_accvgpr_write_b32 a81, 0
    v_accvgpr_write_b32 a82, 0
    v_accvgpr_write_b32 a83, 0
    v_accvgpr_write_b32 a84, 0
    buffer_load_dwordx4 a[196:199], v7, s[32:35], s63 offen offset:2048
    s_add_u32 s85, s85, 3072
    s_cmp_eq_u32 s85, 21504
    s_cselect_b32 s85, 0, s85
    s_add_u32 s63, s83, s85
    buffer_load_dwordx4 a[200:203], v7, s[32:35], s63 offen offset:0
    v_accvgpr_write_b32 a85, 0
    v_accvgpr_write_b32 a86, 0
    v_accvgpr_write_b32 a87, 0
    v_accvgpr_write_b32 a88, 0
    v_accvgpr_write_b32 a89, 0
    v_accvgpr_write_b32 a90, 0
    v_accvgpr_write_b32 a91, 0
    buffer_load_dwordx4 a[204:207], v7, s[32:35], s63 offen offset:1024
    v_accvgpr_write_b32 a92, 0
    v_accvgpr_write_b32 a93, 0
    v_accvgpr_write_b32 a94, 0
    v_accvgpr_write_b32 a95, 0
    buffer_load_dwordx4 a[208:211], v7, s[32:35], s63 offen offset:2048
    s_add_u32 s63, s83, s84
    s_mov_b32 s85, s84
    s_lshr_b32 s63, s63, 2
    v_add_u32 v28, s63, v10
    s_waitcnt vmcnt(20)
    ds_write_b128 v28, a[128:131] offset:0
    buffer_load_dwordx4 v[128:131], v1, s[24:27], s57 offen offset:0
    s_add_u32 s85, s85, 3072
    s_cmp_eq_u32 s85, 21504
    s_cselect_b32 s85, 0, s85
    s_add_u32 s63, s83, s85
    s_lshr_b32 s63, s63, 2
    v_add_u32 v29, s63, v10
    s_waitcnt vmcnt(20)
    ds_write_b128 v28, a[132:135] offset:256
    buffer_load_dwordx4 v[132:135], v1, s[24:27], s57 offen offset:256
    ds_read_b128 v[112:115], v17 offset:0
    ds_read_b128 v[116:119], v17 offset:16
    ds_read_b128 v[120:123], v17 offset:32
    ds_read_b128 v[124:127], v17 offset:48
    ds_read_b128 v[48:51], v17 offset:512
    ds_read_b128 v[52:55], v17 offset:528
    s_waitcnt vmcnt(20)
    ds_write_b128 v28, a[136:139] offset:512
    buffer_load_dwordx4 v[136:139], v1, s[24:27], s57 offen offset:512
    ds_read_b128 v[56:59], v17 offset:544
    ds_read_b128 v[60:63], v17 offset:560
    ds_read2_b32 v[64:65], v3 offset0:0 offset1:1
    ds_read2_b32 v[66:67], v3 offset0:2 offset1:3
    ds_read2_b32 v[68:69], v3 offset0:4 offset1:5
    ds_read2_b32 v[70:71], v3 offset0:6 offset1:7
    s_waitcnt vmcnt(20)
    ds_write_b128 v29, a[140:143] offset:0
    buffer_load_dwordx4 v[140:143], v1, s[24:27], s57 offen offset:768
    s_add_u32 s85, s85, 3072
    s_cmp_eq_u32 s85, 21504
    s_cselect_b32 s85, 0, s85
    s_add_u32 s63, s83, s85
    s_lshr_b32 s63, s63, 2
    v_add_u32 v28, s63, v10
    s_waitcnt vmcnt(20)
    ds_write_b128 v29, a[144:147] offset:256
    buffer_load_dwordx4 v[144:147], v1, s[24:27], s57 offen offset:1024
    s_waitcnt lgkmcnt(0)
    v_lshlrev_b32 v80, 16, v112
    v_lshlrev_b32 v81, 16, v116
    v_lshlrev_b32 v82, 16, v120
    v_lshlrev_b32 v83, 16, v124
    v_and_b32 v84, 0xffff0000, v112
    v_and_b32 v85, 0xffff0000, v116
    v_and_b32 v86, 0xffff0000, v120
    s_waitcnt vmcnt(20)
    ds_write_b128 v29, a[148:151] offset:512
    buffer_load_dwordx4 v[148:151], v1, s[24:27], s57 offen offset:1280
    v_and_b32 v87, 0xffff0000, v124
    v_lshlrev_b32 v88, 16, v113
    v_lshlrev_b32 v89, 16, v117
    v_lshlrev_b32 v90, 16, v121
    v_lshlrev_b32 v91, 16, v125
    v_and_b32 v92, 0xffff0000, v113
    v_and_b32 v93, 0xffff0000, v117
    s_waitcnt vmcnt(20)
    ds_write_b128 v28, a[152:155] offset:0
    buffer_load_dwordx4 v[152:155], v1, s[24:27], s57 offen offset:1536
    s_add_u32 s85, s85, 3072
    s_cmp_eq_u32 s85, 21504
    s_cselect_b32 s85, 0, s85
    s_add_u32 s63, s83, s85
    s_lshr_b32 s63, s63, 2
    v_add_u32 v29, s63, v10
    s_waitcnt vmcnt(20)
    ds_write_b128 v28, a[156:159] offset:256
    buffer_load_dwordx4 v[156:159], v1, s[24:27], s57 offen offset:1792
    v_and_b32 v94, 0xffff0000, v121
    v_and_b32 v95, 0xffff0000, v125
    v_lshlrev_b32 v96, 16, v114
    v_lshlrev_b32 v97, 16, v118
    v_lshlrev_b32 v98, 16, v122
    v_lshlrev_b32 v99, 16, v126
    v_and_b32 v100, 0xffff0000, v114
    s_waitcnt vmcnt(20)
    ds_write_b128 v28, a[160:163] offset:512
    buffer_load_dwordx4 v[160:163], v1, s[24:27], s58 offen offset:0
    v_and_b32 v101, 0xffff0000, v118
    v_and_b32 v102, 0xffff0000, v122
    v_and_b32 v103, 0xffff0000, v126
    v_lshlrev_b32 v104, 16, v115
    v_lshlrev_b32 v105, 16, v119
    v_lshlrev_b32 v106, 16, v123
    v_lshlrev_b32 v107, 16, v127
    s_waitcnt vmcnt(20)
    ds_write_b128 v29, a[164:167] offset:0
    buffer_load_dwordx4 v[164:167], v1, s[24:27], s58 offen offset:256
    s_add_u32 s85, s85, 3072
    s_cmp_eq_u32 s85, 21504
    s_cselect_b32 s85, 0, s85
    s_add_u32 s63, s83, s85
    s_lshr_b32 s63, s63, 2
    v_add_u32 v28, s63, v10
    s_waitcnt vmcnt(20)
    ds_write_b128 v29, a[168:171] offset:256
    buffer_load_dwordx4 v[168:171], v1, s[24:27], s58 offen offset:512
    v_and_b32 v108, 0xffff0000, v115
    v_and_b32 v109, 0xffff0000, v119
    v_and_b32 v110, 0xffff0000, v123
    v_and_b32 v111, 0xffff0000, v127
    s_and_b32 s70, s70, 0xffff
    v_alignbyte_b32 v64, v65, v64, v4
    v_alignbyte_b32 v65, v66, v65, v4
    s_waitcnt vmcnt(20)
    ds_write_b128 v29, a[172:175] offset:512
    buffer_load_dwordx4 v[172:175], v1, s[24:27], s58 offen offset:768
    v_alignbyte_b32 v66, v67, v66, v4
    v_alignbyte_b32 v67, v68, v67, v4
    v_alignbyte_b32 v68, v69, v68, v4
    v_alignbyte_b32 v69, v70, v69, v4
    v_alignbyte_b32 v70, v71, v70, v4
    v_dot2_f32_bf16 v12, v64, s64, 0
    v_dot2_f32_bf16 v12, v65, s65, v12
    s_waitcnt vmcnt(20)
    ds_write_b128 v28, a[176:179] offset:0
    buffer_load_dwordx4 v[176:179], v1, s[24:27], s58 offen offset:1024
    s_add_u32 s85, s85, 3072
    s_cmp_eq_u32 s85, 21504
    s_cselect_b32 s85, 0, s85
    s_add_u32 s63, s83, s85
    s_lshr_b32 s63, s63, 2
    v_add_u32 v29, s63, v10
    s_waitcnt vmcnt(20)
    ds_write_b128 v28, a[180:183] offset:256
    buffer_load_dwordx4 v[180:183], v1, s[24:27], s58 offen offset:1280
    v_dot2_f32_bf16 v12, v66, s66, v12
    v_dot2_f32_bf16 v12, v67, s67, v12
    v_dot2_f32_bf16 v12, v68, s68, v12
    v_dot2_f32_bf16 v12, v69, s69, v12
    v_dot2_f32_bf16 v12, v70, s70, v12
    s_lshl_b32 s72, s72, 16
    s_lshl_b32 s73, s73, 16
    s_waitcnt vmcnt(20)
    ds_write_b128 v28, a[184:187] offset:512
    buffer_load_dwordx4 v[184:187], v1, s[24:27], s58 offen offset:1536
    s_nop 1
    v_cvt_pk_bf16_f32 v12, 0, v12
    v_add_f32 v12, s72, v12
    v_cvt_pk_bf16_f32 v12, 0, v12
    s_waitcnt vmcnt(20)
    ds_write_b128 v29, a[188:191] offset:0
    buffer_load_dwordx4 v[188:191], v1, s[24:27], s58 offen offset:1792
    s_add_u32 s85, s85, 3072
    s_cmp_eq_u32 s85, 21504
    s_cselect_b32 s85, 0, s85
    s_add_u32 s63, s83, s85
    s_lshr_b32 s63, s63, 2
    v_add_u32 v28, s63, v10
    s_waitcnt vmcnt(20)
    ds_write_b128 v29, a[192:195] offset:256
    buffer_load_dwordx4 v[192:195], v1, s[24:27], s59 offen offset:0
    s_waitcnt vmcnt(20)
    ds_write_b128 v29, a[196:199] offset:512
    s_waitcnt vmcnt(19)
    ds_write_b128 v28, a[200:203] offset:0
    s_waitcnt vmcnt(18)
    ds_write_b128 v28, a[204:207] offset:256
    s_waitcnt vmcnt(17)
    ds_write_b128 v28, a[208:211] offset:512
    s_waitcnt lgkmcnt(0)
    s_branch L_join
L_idxwave:
    s_mov_b32 m0, 114400
    s_add_u32 s28, s4, s75
    s_addc_u32 s29, s5, 0
    buffer_load_dwordx4 v7, s[28:31], s82 offen offset:0 lds
    s_mov_b32 s24, s14
    s_mov_b32 s25, s15
    s_mov_b32 s48, s22
    s_mov_b32 s49, s23
    buffer_load_dwordx4 v7, s[28:31], s82 offen offset:1024 lds
    s_load_dwordx8 s[64:71], s[10:11], 0
    s_load_dword s72, s[12:13], 0
    s_load_dword s73, s[20:21], 0
    v_accvgpr_write_b32 a8, 0
    buffer_load_dwordx4 v7, s[28:31], s82 offen offset:2048 lds
    v_accvgpr_write_b32 a9, 0
    v_accvgpr_write_b32 a10, 0
    v_accvgpr_write_b32 a11, 0
    v_accvgpr_write_b32 a12, 0
    buffer_load_dwordx4 v7, s[28:31], s82 offen offset:3072 lds
    s_add_u32 s82, s82, 4096
    s_add_u32 m0, s82, 114400
    v_accvgpr_write_b32 a13, 0
    v_accvgpr_write_b32 a14, 0
    v_accvgpr_write_b32 a15, 0
    v_accvgpr_write_b32 a16, 0
    buffer_load_dwordx4 v7, s[28:31], s82 offen offset:0 lds
    v_accvgpr_write_b32 a17, 0
    v_accvgpr_write_b32 a18, 0
    v_accvgpr_write_b32 a19, 0
    v_accvgpr_write_b32 a20, 0
    buffer_load_dwordx4 v7, s[28:31], s82 offen offset:1024 lds
    v_accvgpr_write_b32 a21, 0
    v_accvgpr_write_b32 a22, 0
    v_accvgpr_write_b32 a23, 0
    v_accvgpr_write_b32 a24, 0
    buffer_load_dwordx4 v7, s[28:31], s82 offen offset:2048 lds
    v_accvgpr_write_b32 a25, 0
    v_accvgpr_write_b32 a26, 0
    v_accvgpr_write_b32 a27, 0
    v_accvgpr_write_b32 a28, 0
    buffer_load_dwordx4 v7, s[28:31], s82 offen offset:3072 lds
    s_add_u32 s82, s82, 4096
    s_add_u32 m0, s82, 114400
    v_accvgpr_write_b32 a29, 0
    v_accvgpr_write_b32 a30, 0
    v_accvgpr_write_b32 a31, 0
    v_accvgpr_write_b32 a32, 0
    buffer_load_dwordx4 v7, s[28:31], s82 offen offset:0 lds
    v_accvgpr_write_b32 a33, 0
    v_accvgpr_write_b32 a34, 0
    v_accvgpr_write_b32 a35, 0
    v_accvgpr_write_b32 a36, 0
    buffer_load_dwordx4 v7, s[28:31], s82 offen offset:1024 lds
    v_accvgpr_write_b32 a37, 0
    v_accvgpr_write_b32 a38, 0
    v_accvgpr_write_b32 a39, 0
    v_accvgpr_write_b32 a40, 0
    buffer_load_dwordx4 v7, s[28:31], s82 offen offset:2048 lds
    v_accvgpr_write_b32 a41, 0
    v_accvgpr_write_b32 a42, 0
    v_accvgpr_write_b32 a43, 0
    v_accvgpr_write_b32 a44, 0
    buffer_load_dwordx4 v7, s[28:31], s82 offen offset:3072 lds
    s_add_u32 s82, s82, 4096
    s_add_u32 m0, s82, 114400
    v_accvgpr_write_b32 a45, 0
    v_accvgpr_write_b32 a46, 0
    v_accvgpr_write_b32 a47, 0
    v_accvgpr_write_b32 a48, 0
    buffer_load_dwordx4 v7, s[28:31], s82 offen offset:0 lds
    v_accvgpr_write_b32 a49, 0
    v_accvgpr_write_b32 a50, 0
    v_accvgpr_write_b32 a51, 0
    v_accvgpr_write_b32 a52, 0
    buffer_load_dwordx4 v7, s[28:31], s82 offen offset:1024 lds
    v_accvgpr_write_b32 a53, 0
    v_accvgpr_write_b32 a54, 0
    v_accvgpr_write_b32 a55, 0
    v_accvgpr_write_b32 a56, 0
    buffer_load_dwordx4 v7, s[28:31], s82 offen offset:2048 lds
    v_accvgpr_write_b32 a57, 0
    v_accvgpr_write_b32 a58, 0
    v_accvgpr_write_b32 a59, 0
    v_accvgpr_write_b32 a60, 0
    buffer_load_dwordx4 v7, s[28:31], s82 offen offset:3072 lds
    s_add_u32 s82, s82, 4096
    s_add_u32 m0, s82, 114400
    v_accvgpr_write_b32 a61, 0
    v_accvgpr_write_b32 a62, 0
    v_accvgpr_write_b32 a63, 0
    v_accvgpr_write_b32 a64, 0
    buffer_load_dwordx4 v7, s[28:31], s82 offen offset:0 lds
    v_accvgpr_write_b32 a65, 0
    v_accvgpr_write_b32 a66, 0
    v_accvgpr_write_b32 a67, 0
    v_accvgpr_write_b32 a68, 0
    buffer_load_dwordx4 v7, s[28:31], s82 offen offset:1024 lds
    v_accvgpr_write_b32 a69, 0
    v_accvgpr_write_b32 a70, 0
    v_accvgpr_write_b32 a71, 0
    v_accvgpr_write_b32 a72, 0
    buffer_load_dwordx4 v7, s[28:31], s82 offen offset:2048 lds
    v_accvgpr_write_b32 a73, 0
    v_accvgpr_write_b32 a74, 0
    v_accvgpr_write_b32 a75, 0
    v_accvgpr_write_b32 a76, 0
    buffer_load_dwordx4 v7, s[28:31], s82 offen offset:3072 lds
    s_add_u32 s82, s82, 4096
    s_add_u32 m0, s82, 114400
    v_accvgpr_write_b32 a77, 0
    v_accvgpr_write_b32 a78, 0
    v_accvgpr_write_b32 a79, 0
    v_accvgpr_write_b32 a80, 0
    buffer_load_dwordx4 v7, s[28:31], s82 offen offset:0 lds
    v_accvgpr_write_b32 a81, 0
    v_accvgpr_write_b32 a82, 0
    v_accvgpr_write_b32 a83, 0
    v_accvgpr_write_b32 a84, 0
    buffer_load_dwordx4 v7, s[28:31], s82 offen offset:1024 lds
    v_accvgpr_write_b32 a85, 0
    v_accvgpr_write_b32 a86, 0
    v_accvgpr_write_b32 a87, 0
    v_accvgpr_write_b32 a88, 0
    buffer_load_dwordx4 v7, s[28:31], s82 offen offset:2048 lds
    v_accvgpr_write_b32 a89, 0
    v_accvgpr_write_b32 a90, 0
    v_accvgpr_write_b32 a91, 0
    v_accvgpr_write_b32 a92, 0
    buffer_load_dwordx4 v7, s[28:31], s82 offen offset:3072 lds
    s_add_u32 s82, s82, 4096
    s_add_u32 m0, s82, 114400
    v_accvgpr_write_b32 a93, 0
    v_accvgpr_write_b32 a94, 0
    v_accvgpr_write_b32 a95, 0
    buffer_load_dwordx4 v7, s[28:31], s82 offen offset:0 lds
    s_waitcnt vmcnt(25)
    ds_read_b128 v[112:115], v17 offset:0
    ds_read_b128 v[116:119], v17 offset:16
    ds_read_b128 v[120:123], v17 offset:32
    ds_read_b128 v[124:127], v17 offset:48
    ds_read_b128 v[48:51], v17 offset:512
    ds_read_b128 v[52:55], v17 offset:528
    ds_read_b128 v[56:59], v17 offset:544
    ds_read_b128 v[60:63], v17 offset:560
    ds_read2_b32 v[64:65], v3 offset0:0 offset1:1
    ds_read2_b32 v[66:67], v3 offset0:2 offset1:3
    ds_read2_b32 v[68:69], v3 offset0:4 offset1:5
    ds_read2_b32 v[70:71], v3 offset0:6 offset1:7
    buffer_load_dwordx4 v[128:131], v1, s[24:27], s57 offen offset:0
    buffer_load_dwordx4 v[132:135], v1, s[24:27], s57 offen offset:256
    buffer_load_dwordx4 v[136:139], v1, s[24:27], s57 offen offset:512
    s_waitcnt lgkmcnt(0)
    buffer_load_dwordx4 v[140:143], v1, s[24:27], s57 offen offset:768
    v_lshlrev_b32 v80, 16, v112
    v_lshlrev_b32 v81, 16, v116
    v_lshlrev_b32 v82, 16, v120
    v_lshlrev_b32 v83, 16, v124
    buffer_load_dwordx4 v[144:147], v1, s[24:27], s57 offen offset:1024
    v_and_b32 v84, 0xffff0000, v112
    v_and_b32 v85, 0xffff0000, v116
    v_and_b32 v86, 0xffff0000, v120
    v_and_b32 v87, 0xffff0000, v124
    buffer_load_dwordx4 v[148:151], v1, s[24:27], s57 offen offset:1280
    v_lshlrev_b32 v88, 16, v113
    v_lshlrev_b32 v89, 16, v117
    v_lshlrev_b32 v90, 16, v121
    v_lshlrev_b32 v91, 16, v125
    buffer_load_dwordx4 v[152:155], v1, s[24:27], s57 offen offset:1536
    v_and_b32 v92, 0xffff0000, v113
    v_and_b32 v93, 0xffff0000, v117
    v_and_b32 v94, 0xffff0000, v121
    v_and_b32 v95, 0xffff0000, v125
    buffer_load_dwordx4 v[156:159], v1, s[24:27], s57 offen offset:1792
    v_lshlrev_b32 v96, 16, v114
    v_lshlrev_b32 v97, 16, v118
    v_lshlrev_b32 v98, 16, v122
    v_lshlrev_b32 v99, 16, v126
    buffer_load_dwordx4 v[160:163], v1, s[24:27], s58 offen offset:0
    v_and_b32 v100, 0xffff0000, v114
    v_and_b32 v101, 0xffff0000, v118
    v_and_b32 v102, 0xffff0000, v122
    v_and_b32 v103, 0xffff0000, v126
    buffer_load_dwordx4 v[164:167], v1, s[24:27], s58 offen offset:256
    v_lshlrev_b32 v104, 16, v115
    v_lshlrev_b32 v105, 16, v119
    v_lshlrev_b32 v106, 16, v123
    v_lshlrev_b32 v107, 16, v127
    buffer_load_dwordx4 v[168:171], v1, s[24:27], s58 offen offset:512
    v_and_b32 v108, 0xffff0000, v115
    v_and_b32 v109, 0xffff0000, v119
    v_and_b32 v110, 0xffff0000, v123
    v_and_b32 v111, 0xffff0000, v127
    buffer_load_dwordx4 v[172:175], v1, s[24:27], s58 offen offset:768
    s_and_b32 s70, s70, 0xffff
    v_alignbyte_b32 v64, v65, v64, v4
    v_alignbyte_b32 v65, v66, v65, v4
    v_alignbyte_b32 v66, v67, v66, v4
    buffer_load_dwordx4 v[176:179], v1, s[24:27], s58 offen offset:1024
    v_alignbyte_b32 v67, v68, v67, v4
    v_alignbyte_b32 v68, v69, v68, v4
    v_alignbyte_b32 v69, v70, v69, v4
    v_alignbyte_b32 v70, v71, v70, v4
    buffer_load_dwordx4 v[180:183], v1, s[24:27], s58 offen offset:1280
    v_dot2_f32_bf16 v12, v64, s64, 0
    v_dot2_f32_bf16 v12, v65, s65, v12
    v_dot2_f32_bf16 v12, v66, s66, v12
    v_dot2_f32_bf16 v12, v67, s67, v12
    buffer_load_dwordx4 v[184:187], v1, s[24:27], s58 offen offset:1536
    v_dot2_f32_bf16 v12, v68, s68, v12
    v_dot2_f32_bf16 v12, v69, s69, v12
    v_dot2_f32_bf16 v12, v70, s70, v12
    s_lshl_b32 s72, s72, 16
    buffer_load_dwordx4 v[188:191], v1, s[24:27], s58 offen offset:1792
    s_lshl_b32 s73, s73, 16
    s_nop 1
    v_cvt_pk_bf16_f32 v12, 0, v12
    v_add_f32 v12, s72, v12
    buffer_load_dwordx4 v[192:195], v1, s[24:27], s59 offen offset:0
    v_cvt_pk_bf16_f32 v12, 0, v12
    s_waitcnt vmcnt(17)
L_join:
    s_barrier
    ds_read_b128 v[68:71], v45
    ds_read_b128 v[72:75], v46
    ds_read_b128 v[76:79], v47
    ds_read_b128 v[64:67], v44
    ds_read_b32 v20, v24
    ds_read_b32 v21, v25
    ds_read_b32 v22, v26
    ds_read_b32 v23, v27
    buffer_load_dwordx4 v[196:199], v1, s[24:27], s59 offen offset:256
    v_mov_b32 v24, v44
    v_mov_b32 v25, v45
    v_mov_b32 v26, v46
    v_mov_b32 v27, v47
    s_waitcnt lgkmcnt(7)
    v_lshl_add_u32 v45, v68, 4, v2
    ds_read_b128 a[100:103], v45
    s_waitcnt lgkmcnt(7)
    v_lshl_add_u32 v46, v72, 4, v2
    ds_read_b128 a[104:107], v46
    s_waitcnt lgkmcnt(7)
    v_lshl_add_u32 v47, v76, 4, v2
    ds_read_b128 a[108:111], v47
    s_waitcnt lgkmcnt(7)
    v_lshl_add_u32 v44, v64, 4, v2
    ds_read_b128 a[96:99], v44
    s_waitcnt vmcnt(10)
    buffer_load_dwordx4 v[200:203], v1, s[24:27], s59 offen offset:512
    v_perm_b32 v112, v132, v128, s53
    v_perm_b32 v113, v140, v136, s53
    buffer_load_dwordx4 v[204:207], v1, s[24:27], s59 offen offset:768
    v_perm_b32 v114, v148, v144, s53
    v_perm_b32 v115, v156, v152, s53
    buffer_load_dwordx4 v[208:211], v1, s[24:27], s59 offen offset:1024
    v_perm_b32 v116, v132, v128, s54
    v_perm_b32 v117, v140, v136, s54
    buffer_load_dwordx4 v[212:215], v1, s[24:27], s59 offen offset:1280
    v_perm_b32 v118, v148, v144, s54
    v_perm_b32 v119, v156, v152, s54
    s_waitcnt lgkmcnt(4)
    ds_write_b32 v24, v20
    ds_write_b32 v25, v21
    ds_write_b32 v26, v22
    ds_write_b32 v27, v23
    s_waitcnt lgkmcnt(4)
L_loop:
    v_mfma_f32_16x16x32_bf16 a[0:3], v[112:115], a[100:103], a[0:3]
    v_perm_b32 v120, v133, v129, s53
    v_lshl_add_u32 v45, v69, 4, v2
    v_mfma_f32_16x16x32_bf16 a[32:35], v[112:115], a[104:107], a[32:35]
    buffer_load_dwordx4 v[216:219], v1, s[24:27], s59 offen offset:1536
    v_perm_b32 v121, v141, v137, s53
    v_mfma_f32_16x16x32_bf16 a[64:67], v[112:115], a[108:111], a[64:67]
    ds_read_b128 a[116:119], v45
    v_perm_b32 v122, v149, v145, s53
    v_mfma_f32_16x16x32_bf16 v[80:83], v[112:115], a[96:99], v[80:83]
    v_perm_b32 v123, v157, v153, s53
    v_mfma_f32_16x16x32_bf16 a[4:7], v[116:119], a[100:103], a[4:7]
    v_perm_b32 v124, v133, v129, s54
    v_lshl_add_u32 v46, v73, 4, v2
    v_mfma_f32_16x16x32_bf16 a[36:39], v[116:119], a[104:107], a[36:39]
    buffer_load_dwordx4 v[220:223], v1, s[24:27], s59 offen offset:1792
    v_perm_b32 v125, v141, v137, s54
    v_mfma_f32_16x16x32_bf16 a[68:71], v[116:119], a[108:111], a[68:71]
    ds_read_b128 a[120:123], v46
    v_perm_b32 v126, v149, v145, s54
    v_mfma_f32_16x16x32_bf16 v[84:87], v[116:119], a[96:99], v[84:87]
    v_perm_b32 v127, v157, v153, s54
    v_mfma_f32_16x16x32_bf16 a[8:11], v[120:123], a[100:103], a[8:11]
    v_perm_b32 v112, v134, v130, s53
    v_lshl_add_u32 v47, v77, 4, v2
    v_mfma_f32_16x16x32_bf16 a[40:43], v[120:123], a[104:107], a[40:43]
    buffer_load_dwordx4 v[224:227], v1, s[24:27], s60 offen offset:0
    v_perm_b32 v113, v142, v138, s53
    v_mfma_f32_16x16x32_bf16 a[72:75], v[120:123], a[108:111], a[72:75]
    ds_read_b128 a[124:127], v47
    v_perm_b32 v114, v150, v146, s53
    v_mfma_f32_16x16x32_bf16 v[88:91], v[120:123], a[96:99], v[88:91]
    v_perm_b32 v115, v158, v154, s53
    v_mfma_f32_16x16x32_bf16 a[12:15], v[124:127], a[100:103], a[12:15]
    v_perm_b32 v116, v134, v130, s54
    v_lshl_add_u32 v44, v65, 4, v2
    v_mfma_f32_16x16x32_bf16 a[44:47], v[124:127], a[104:107], a[44:47]
    buffer_load_dwordx4 v[228:231], v1, s[24:27], s60 offen offset:256
    v_perm_b32 v117, v142, v138, s54
    v_mfma_f32_16x16x32_bf16 a[76:79], v[124:127], a[108:111], a[76:79]
    ds_read_b128 a[112:115], v44
    v_perm_b32 v118, v150, v146, s54
    v_mfma_f32_16x16x32_bf16 v[92:95], v[124:127], a[96:99], v[92:95]
    v_perm_b32 v119, v158, v154, s54
    s_add_u32 s56, s56, 0x20000
    v_mfma_f32_16x16x32_bf16 a[16:19], v[112:115], a[100:103], a[16:19]
    v_perm_b32 v120, v135, v131, s53
    s_sub_u32 s63, s56, 0xc0000
    v_mfma_f32_16x16x32_bf16 a[48:51], v[112:115], a[104:107], a[48:51]
    buffer_load_dwordx4 v[232:235], v1, s[24:27], s60 offen offset:512
    v_perm_b32 v121, v143, v139, s53
    v_mfma_f32_16x16x32_bf16 a[80:83], v[112:115], a[108:111], a[80:83]
    v_perm_b32 v122, v151, v147, s53
    s_cmp_ge_u32 s56, 0xc0000
    v_mfma_f32_16x16x32_bf16 v[96:99], v[112:115], a[96:99], v[96:99]
    v_perm_b32 v123, v159, v155, s53
    s_cselect_b32 s56, s63, s56
    v_mfma_f32_16x16x32_bf16 a[20:23], v[116:119], a[100:103], a[20:23]
    v_perm_b32 v124, v135, v131, s54
    s_cmp_eq_u32 s55, 5
    v_mfma_f32_16x16x32_bf16 a[52:55], v[116:119], a[104:107], a[52:55]
    buffer_load_dwordx4 v[236:239], v1, s[24:27], s60 offen offset:768
    v_perm_b32 v125, v143, v139, s54
    v_mfma_f32_16x16x32_bf16 a[84:87], v[116:119], a[108:111], a[84:87]
    v_perm_b32 v126, v151, v147, s54
    s_cselect_b32 s57, s61, s56
    v_mfma_f32_16x16x32_bf16 v[100:103], v[116:119], a[96:99], v[100:103]
    v_perm_b32 v127, v159, v155, s54
    s_cselect_b32 s63, 0x7ff00000, s56
    v_mfma_f32_16x16x32_bf16 a[24:27], v[120:123], a[100:103], a[24:27]
    s_waitcnt vmcnt(12)
    v_perm_b32 v112, v164, v160, s53
    v_mfma_f32_16x16x32_bf16 a[56:59], v[120:123], a[104:107], a[56:59]
    buffer_load_dwordx4 v[240:243], v1, s[24:27], s60 offen offset:1024
    v_perm_b32 v113, v172, v168, s53
    v_mfma_f32_16x16x32_bf16 a[88:91], v[120:123], a[108:111], a[88:91]
    v_perm_b32 v114, v180, v176, s53
    s_add_u32 s58, s63, 8192
    v_mfma_f32_16x16x32_bf16 v[104:107], v[120:123], a[96:99], v[104:107]
    v_perm_b32 v115, v188, v184, s53
    s_add_u32 s59, s63, 16384
    v_mfma_f32_16x16x32_bf16 a[28:31], v[124:127], a[100:103], a[28:31]
    v_perm_b32 v116, v164, v160, s54
    v_mfma_f32_16x16x32_bf16 a[60:63], v[124:127], a[104:107], a[60:63]
    buffer_load_dwordx4 v[244:247], v1, s[24:27], s60 offen offset:1280
    v_perm_b32 v117, v172, v168, s54
    v_mfma_f32_16x16x32_bf16 a[92:95], v[124:127], a[108:111], a[92:95]
    v_perm_b32 v118, v180, v176, s54
    s_lshr_b32 s78, s56, 11
    v_mfma_f32_16x16x32_bf16 v[108:111], v[124:127], a[96:99], v[108:111]
    v_perm_b32 v119, v188, v184, s54
    s_waitcnt lgkmcnt(0)
    v_mfma_f32_16x16x32_bf16 a[0:3], v[112:115], a[116:119], a[0:3]
    v_perm_b32 v120, v165, v161, s53
    v_lshl_add_u32 v45, v70, 4, v2
    v_mfma_f32_16x16x32_bf16 a[32:35], v[112:115], a[120:123], a[32:35]
    buffer_load_dwordx4 v[248:251], v1, s[24:27], s60 offen offset:1536
    v_perm_b32 v121, v173, v169, s53
    v_mfma_f32_16x16x32_bf16 a[64:67], v[112:115], a[124:127], a[64:67]
    ds_read_b128 a[100:103], v45
    v_perm_b32 v122, v181, v177, s53
    v_mfma_f32_16x16x32_bf16 v[80:83], v[112:115], a[112:115], v[80:83]
    v_perm_b32 v123, v189, v185, s53
    v_mfma_f32_16x16x32_bf16 a[4:7], v[116:119], a[116:119], a[4:7]
    v_perm_b32 v124, v165, v161, s54
    v_lshl_add_u32 v46, v74, 4, v2
    v_mfma_f32_16x16x32_bf16 a[36:39], v[116:119], a[120:123], a[36:39]
    buffer_load_dwordx4 v[252:255], v1, s[24:27], s60 offen offset:1792
    v_perm_b32 v125, v173, v169, s54
    v_mfma_f32_16x16x32_bf16 a[68:71], v[116:119], a[124:127], a[68:71]
    ds_read_b128 a[104:107], v46
    v_perm_b32 v126, v181, v177, s54
    v_mfma_f32_16x16x32_bf16 v[84:87], v[116:119], a[112:115], v[84:87]
    v_perm_b32 v127, v189, v185, s54
    v_mfma_f32_16x16x32_bf16 a[8:11], v[120:123], a[116:119], a[8:11]
    v_perm_b32 v112, v166, v162, s53
    v_lshl_add_u32 v47, v78, 4, v2
    v_mfma_f32_16x16x32_bf16 a[40:43], v[120:123], a[120:123], a[40:43]
    buffer_load_dwordx4 v[128:131], v1, s[24:27], s57 offen offset:0
    v_perm_b32 v113, v174, v170, s53
    v_mfma_f32_16x16x32_bf16 a[72:75], v[120:123], a[124:127], a[72:75]
    ds_read_b128 a[108:111], v47
    v_perm_b32 v114, v182, v178, s53
    v_mfma_f32_16x16x32_bf16 v[88:91], v[120:123], a[112:115], v[88:91]
    v_perm_b32 v115, v190, v186, s53
    v_mfma_f32_16x16x32_bf16 a[12:15], v[124:127], a[116:119], a[12:15]
    v_perm_b32 v116, v166, v162, s54
    v_lshl_add_u32 v44, v66, 4, v2
    v_mfma_f32_16x16x32_bf16 a[44:47], v[124:127], a[120:123], a[44:47]
    buffer_load_dwordx4 v[132:135], v1, s[24:27], s57 offen offset:256
    v_perm_b32 v117, v174, v170, s54
    v_mfma_f32_16x16x32_bf16 a[76:79], v[124:127], a[124:127], a[76:79]
    ds_read_b128 a[96:99], v44
    v_perm_b32 v118, v182, v178, s54
    v_mfma_f32_16x16x32_bf16 v[92:95], v[124:127], a[112:115], v[92:95]
    v_perm_b32 v119, v190, v186, s54
    v_mfma_f32_16x16x32_bf16 a[16:19], v[112:115], a[116:119], a[16:19]
    v_perm_b32 v120, v167, v163, s53
    s_add_u32 s55, s55, 1
    v_mfma_f32_16x16x32_bf16 a[48:51], v[112:115], a[120:123], a[48:51]
    buffer_load_dwordx4 v[136:139], v1, s[24:27], s57 offen offset:512
    v_perm_b32 v121, v175, v171, s53
    v_mfma_f32_16x16x32_bf16 a[80:83], v[112:115], a[124:127], a[80:83]
    v_perm_b32 v122, v183, v179, s53
    v_mfma_f32_16x16x32_bf16 v[96:99], v[112:115], a[112:115], v[96:99]
    v_perm_b32 v123, v191, v187, s53
    v_mfma_f32_16x16x32_bf16 a[20:23], v[116:119], a[116:119], a[20:23]
    v_perm_b32 v124, v167, v163, s54
    s_add_u32 s60, s63, 24576
    v_mfma_f32_16x16x32_bf16 a[52:55], v[116:119], a[120:123], a[52:55]
    buffer_load_dwordx4 v[140:143], v1, s[24:27], s57 offen offset:768
    v_perm_b32 v125, v175, v171, s54
    v_mfma_f32_16x16x32_bf16 a[84:87], v[116:119], a[124:127], a[84:87]
    v_perm_b32 v126, v183, v179, s54
    v_mfma_f32_16x16x32_bf16 v[100:103], v[116:119], a[112:115], v[100:103]
    v_perm_b32 v127, v191, v187, s54
    v_mfma_f32_16x16x32_bf16 a[24:27], v[120:123], a[116:119], a[24:27]
    s_waitcnt vmcnt(12)
    v_perm_b32 v112, v196, v192, s53
    v_mfma_f32_16x16x32_bf16 a[56:59], v[120:123], a[120:123], a[56:59]
    buffer_load_dwordx4 v[144:147], v1, s[24:27], s57 offen offset:1024
    v_perm_b32 v113, v204, v200, s53
    v_mfma_f32_16x16x32_bf16 a[88:91], v[120:123], a[124:127], a[88:91]
    v_perm_b32 v114, v212, v208, s53
    v_mfma_f32_16x16x32_bf16 v[104:107], v[120:123], a[112:115], v[104:107]
    v_perm_b32 v115, v220, v216, s53
    v_mfma_f32_16x16x32_bf16 a[28:31], v[124:127], a[116:119], a[28:31]
    v_perm_b32 v116, v196, v192, s54
    v_mfma_f32_16x16x32_bf16 a[60:63], v[124:127], a[120:123], a[60:63]
    buffer_load_dwordx4 v[148:151], v1, s[24:27], s57 offen offset:1280
    v_perm_b32 v117, v204, v200, s54
    v_mfma_f32_16x16x32_bf16 a[92:95], v[124:127], a[124:127], a[92:95]
    v_perm_b32 v118, v212, v208, s54
    v_mfma_f32_16x16x32_bf16 v[108:111], v[124:127], a[112:115], v[108:111]
    v_perm_b32 v119, v220, v216, s54
    s_waitcnt lgkmcnt(0)
    v_mfma_f32_16x16x32_bf16 a[0:3], v[112:115], a[100:103], a[0:3]
    v_perm_b32 v120, v197, v193, s53
    v_lshl_add_u32 v45, v71, 4, v2
    v_mfma_f32_16x16x32_bf16 a[32:35], v[112:115], a[104:107], a[32:35]
    buffer_load_dwordx4 v[152:155], v1, s[24:27], s57 offen offset:1536
    v_perm_b32 v121, v205, v201, s53
    v_mfma_f32_16x16x32_bf16 a[64:67], v[112:115], a[108:111], a[64:67]
    ds_read_b128 a[116:119], v45
    v_perm_b32 v122, v213, v209, s53
    v_mfma_f32_16x16x32_bf16 v[80:83], v[112:115], a[96:99], v[80:83]
    v_perm_b32 v123, v221, v217, s53
    v_mfma_f32_16x16x32_bf16 a[4:7], v[116:119], a[100:103], a[4:7]
    v_perm_b32 v124, v197, v193, s54
    v_lshl_add_u32 v46, v75, 4, v2
    v_mfma_f32_16x16x32_bf16 a[36:39], v[116:119], a[104:107], a[36:39]
    buffer_load_dwordx4 v[156:159], v1, s[24:27], s57 offen offset:1792
    v_perm_b32 v125, v205, v201, s54
    v_mfma_f32_16x16x32_bf16 a[68:71], v[116:119], a[108:111], a[68:71]
    ds_read_b128 a[120:123], v46
    v_perm_b32 v126, v213, v209, s54
    v_mfma_f32_16x16x32_bf16 v[84:87], v[116:119], a[96:99], v[84:87]
    v_perm_b32 v127, v221, v217, s54
    v_mfma_f32_16x16x32_bf16 a[8:11], v[120:123], a[100:103], a[8:11]
    v_perm_b32 v112, v198, v194, s53
    v_lshl_add_u32 v47, v79, 4, v2
    v_mfma_f32_16x16x32_bf16 a[40:43], v[120:123], a[104:107], a[40:43]
    buffer_load_dwordx4 v[160:163], v1, s[24:27], s58 offen offset:0
    v_perm_b32 v113, v206, v202, s53
    v_mfma_f32_16x16x32_bf16 a[72:75], v[120:123], a[108:111], a[72:75]
    ds_read_b128 a[124:127], v47
    v_perm_b32 v114, v214, v210, s53
    v_mfma_f32_16x16x32_bf16 v[88:91], v[120:123], a[96:99], v[88:91]
    v_perm_b32 v115, v222, v218, s53
    v_mfma_f32_16x16x32_bf16 a[12:15], v[124:127], a[100:103], a[12:15]
    v_perm_b32 v116, v198, v194, s54
    v_lshl_add_u32 v44, v67, 4, v2
    v_mfma_f32_16x16x32_bf16 a[44:47], v[124:127], a[104:107], a[44:47]
    buffer_load_dwordx4 v[164:167], v1, s[24:27], s58 offen offset:256
    v_perm_b32 v117, v206, v202, s54
    v_mfma_f32_16x16x32_bf16 a[76:79], v[124:127], a[108:111], a[76:79]
    ds_read_b128 a[112:115], v44
    v_perm_b32 v118, v214, v210, s54
    v_mfma_f32_16x16x32_bf16 v[92:95], v[124:127], a[96:99], v[92:95]
    v_perm_b32 v119, v222, v218, s54
    v_mfma_f32_16x16x32_bf16 a[16:19], v[112:115], a[100:103], a[16:19]
    v_perm_b32 v120, v199, v195, s53
    v_add_u32 v44, s78, v40
    v_mfma_f32_16x16x32_bf16 a[48:51], v[112:115], a[104:107], a[48:51]
    buffer_load_dwordx4 v[168:171], v1, s[24:27], s58 offen offset:512
    v_perm_b32 v121, v207, v203, s53
    v_mfma_f32_16x16x32_bf16 a[80:83], v[112:115], a[108:111], a[80:83]
    ds_read_b128 v[64:67], v44
    v_perm_b32 v122, v215, v211, s53
    v_mfma_f32_16x16x32_bf16 v[96:99], v[112:115], a[96:99], v[96:99]
    v_perm_b32 v123, v223, v219, s53
    v_mfma_f32_16x16x32_bf16 a[20:23], v[116:119], a[100:103], a[20:23]
    v_perm_b32 v124, v199, v195, s54
    v_add_u32 v45, s78, v41
    v_mfma_f32_16x16x32_bf16 a[52:55], v[116:119], a[104:107], a[52:55]
    buffer_load_dwordx4 v[172:175], v1, s[24:27], s58 offen offset:768
    v_perm_b32 v125, v207, v203, s54
    v_mfma_f32_16x16x32_bf16 a[84:87], v[116:119], a[108:111], a[84:87]
    ds_read_b128 v[68:71], v45
    v_perm_b32 v126, v215, v211, s54
    v_mfma_f32_16x16x32_bf16 v[100:103], v[116:119], a[96:99], v[100:103]
    v_perm_b32 v127, v223, v219, s54
    v_add_u32 v46, s78, v42
    v_mfma_f32_16x16x32_bf16 a[24:27], v[120:123], a[100:103], a[24:27]
    s_waitcnt vmcnt(12)
    v_perm_b32 v112, v228, v224, s53
    v_mfma_f32_16x16x32_bf16 a[56:59], v[120:123], a[104:107], a[56:59]
    buffer_load_dwordx4 v[176:179], v1, s[24:27], s58 offen offset:1024
    v_perm_b32 v113, v236, v232, s53
    v_mfma_f32_16x16x32_bf16 a[88:91], v[120:123], a[108:111], a[88:91]
    ds_read_b128 v[72:75], v46
    v_perm_b32 v114, v244, v240, s53
    v_mfma_f32_16x16x32_bf16 v[104:107], v[120:123], a[96:99], v[104:107]
    v_perm_b32 v115, v252, v248, s53
    v_mfma_f32_16x16x32_bf16 a[28:31], v[124:127], a[100:103], a[28:31]
    v_perm_b32 v116, v228, v224, s54
    v_add_u32 v47, s78, v43
    v_mfma_f32_16x16x32_bf16 a[60:63], v[124:127], a[104:107], a[60:63]
    buffer_load_dwordx4 v[180:183], v1, s[24:27], s58 offen offset:1280
    v_perm_b32 v117, v236, v232, s54
    v_mfma_f32_16x16x32_bf16 a[92:95], v[124:127], a[108:111], a[92:95]
    ds_read_b128 v[76:79], v47
    v_perm_b32 v118, v244, v240, s54
    v_mfma_f32_16x16x32_bf16 v[108:111], v[124:127], a[96:99], v[108:111]
    v_perm_b32 v119, v252, v248, s54
    s_waitcnt lgkmcnt(0)
    v_mfma_f32_16x16x32_bf16 a[0:3], v[112:115], a[116:119], a[0:3]
    v_perm_b32 v120, v229, v225, s53
    v_lshl_add_u32 v45, v68, 4, v2
    v_mfma_f32_16x16x32_bf16 a[32:35], v[112:115], a[120:123], a[32:35]
    buffer_load_dwordx4 v[184:187], v1, s[24:27], s58 offen offset:1536
    v_perm_b32 v121, v237, v233, s53
    v_mfma_f32_16x16x32_bf16 a[64:67], v[112:115], a[124:127], a[64:67]
    ds_read_b128 a[100:103], v45
    v_perm_b32 v122, v245, v241, s53
    v_mfma_f32_16x16x32_bf16 v[80:83], v[112:115], a[112:115], v[80:83]
    v_perm_b32 v123, v253, v249, s53
    v_mfma_f32_16x16x32_bf16 a[4:7], v[116:119], a[116:119], a[4:7]
    v_perm_b32 v124, v229, v225, s54
    v_lshl_add_u32 v46, v72, 4, v2
    v_mfma_f32_16x16x32_bf16 a[36:39], v[116:119], a[120:123], a[36:39]
    buffer_load_dwordx4 v[188:191], v1, s[24:27], s58 offen offset:1792
    v_perm_b32 v125, v237, v233, s54
    v_mfma_f32_16x16x32_bf16 a[68:71], v[116:119], a[124:127], a[68:71]
    ds_read_b128 a[104:107], v46
    v_perm_b32 v126, v245, v241, s54
    v_mfma_f32_16x16x32_bf16 v[84:87], v[116:119], a[112:115], v[84:87]
    v_perm_b32 v127, v253, v249, s54
    v_mfma_f32_16x16x32_bf16 a[8:11], v[120:123], a[116:119], a[8:11]
    v_perm_b32 v112, v230, v226, s53
    v_lshl_add_u32 v47, v76, 4, v2
    v_mfma_f32_16x16x32_bf16 a[40:43], v[120:123], a[120:123], a[40:43]
    buffer_load_dwordx4 v[192:195], v1, s[24:27], s59 offen offset:0
    v_perm_b32 v113, v238, v234, s53
    v_mfma_f32_16x16x32_bf16 a[72:75], v[120:123], a[124:127], a[72:75]
    ds_read_b128 a[108:111], v47
    v_perm_b32 v114, v246, v242, s53
    v_mfma_f32_16x16x32_bf16 v[88:91], v[120:123], a[112:115], v[88:91]
    v_perm_b32 v115, v254, v250, s53
    v_mfma_f32_16x16x32_bf16 a[12:15], v[124:127], a[116:119], a[12:15]
    v_perm_b32 v116, v230, v226, s54
    v_lshl_add_u32 v44, v64, 4, v2
    v_mfma_f32_16x16x32_bf16 a[44:47], v[124:127], a[120:123], a[44:47]
    buffer_load_dwordx4 v[196:199], v1, s[24:27], s59 offen offset:256
    v_perm_b32 v117, v238, v234, s54
    v_mfma_f32_16x16x32_bf16 a[76:79], v[124:127], a[124:127], a[76:79]
    ds_read_b128 a[96:99], v44
    v_perm_b32 v118, v246, v242, s54
    v_mfma_f32_16x16x32_bf16 v[92:95], v[124:127], a[112:115], v[92:95]
    v_perm_b32 v119, v254, v250, s54
    v_mfma_f32_16x16x32_bf16 a[16:19], v[112:115], a[116:119], a[16:19]
    v_perm_b32 v120, v231, v227, s53
    v_mfma_f32_16x16x32_bf16 a[48:51], v[112:115], a[120:123], a[48:51]
    buffer_load_dwordx4 v[200:203], v1, s[24:27], s59 offen offset:512
    v_perm_b32 v121, v239, v235, s53
    v_mfma_f32_16x16x32_bf16 a[80:83], v[112:115], a[124:127], a[80:83]
    v_perm_b32 v122, v247, v243, s53
    v_mfma_f32_16x16x32_bf16 v[96:99], v[112:115], a[112:115], v[96:99]
    v_perm_b32 v123, v255, v251, s53
    v_mfma_f32_16x16x32_bf16 a[20:23], v[116:119], a[116:119], a[20:23]
    v_perm_b32 v124, v231, v227, s54
    v_mfma_f32_16x16x32_bf16 a[52:55], v[116:119], a[120:123], a[52:55]
    buffer_load_dwordx4 v[204:207], v1, s[24:27], s59 offen offset:768
    v_perm_b32 v125, v239, v235, s54
    v_mfma_f32_16x16x32_bf16 a[84:87], v[116:119], a[124:127], a[84:87]
    v_perm_b32 v126, v247, v243, s54
    v_mfma_f32_16x16x32_bf16 v[100:103], v[116:119], a[112:115], v[100:103]
    v_perm_b32 v127, v255, v251, s54
    v_mfma_f32_16x16x32_bf16 a[24:27], v[120:123], a[116:119], a[24:27]
    s_waitcnt vmcnt(12)
    v_perm_b32 v112, v132, v128, s53
    v_mfma_f32_16x16x32_bf16 a[56:59], v[120:123], a[120:123], a[56:59]
    buffer_load_dwordx4 v[208:211], v1, s[24:27], s59 offen offset:1024
    v_perm_b32 v113, v140, v136, s53
    v_mfma_f32_16x16x32_bf16 a[88:91], v[120:123], a[124:127], a[88:91]
    v_perm_b32 v114, v148, v144, s53
    v_mfma_f32_16x16x32_bf16 v[104:107], v[120:123], a[112:115], v[104:107]
    v_perm_b32 v115, v156, v152, s53
    v_mfma_f32_16x16x32_bf16 a[28:31], v[124:127], a[116:119], a[28:31]
    v_perm_b32 v116, v132, v128, s54
    s_cmp_lt_u32 s55, 6
    v_mfma_f32_16x16x32_bf16 a[60:63], v[124:127], a[120:123], a[60:63]
    buffer_load_dwordx4 v[212:215], v1, s[24:27], s59 offen offset:1280
    v_perm_b32 v117, v140, v136, s54
    v_mfma_f32_16x16x32_bf16 a[92:95], v[124:127], a[124:127], a[92:95]
    v_perm_b32 v118, v148, v144, s54
    v_perm_b32 v119, v156, v152, s54
    v_mfma_f32_16x16x32_bf16 v[108:111], v[124:127], a[112:115], v[108:111]
    s_waitcnt lgkmcnt(0)
    s_cbranch_scc1 L_loop
    v_mfma_f32_16x16x32_bf16 a[0:3], v[112:115], a[100:103], a[0:3]
    v_perm_b32 v120, v133, v129, s53
    v_mfma_f32_16x16x32_bf16 a[32:35], v[112:115], a[104:107], a[32:35]
    v_perm_b32 v121, v141, v137, s53
    v_mfma_f32_16x16x32_bf16 a[64:67], v[112:115], a[108:111], a[64:67]
    v_perm_b32 v122, v149, v145, s53
    v_mfma_f32_16x16x32_bf16 v[80:83], v[112:115], a[96:99], v[80:83]
    v_perm_b32 v123, v157, v153, s53
    v_mfma_f32_16x16x32_bf16 a[4:7], v[116:119], a[100:103], a[4:7]
    v_perm_b32 v124, v133, v129, s54
    v_mfma_f32_16x16x32_bf16 a[36:39], v[116:119], a[104:107], a[36:39]
    ds_write_b128 v13, a[0:3] offset:0
    v_perm_b32 v125, v141, v137, s54
    v_mfma_f32_16x16x32_bf16 a[68:71], v[116:119], a[108:111], a[68:71]
    ds_write_b128 v14, a[32:35] offset:0
    v_perm_b32 v126, v149, v145, s54
    v_mfma_f32_16x16x32_bf16 v[84:87], v[116:119], a[96:99], v[84:87]
    ds_write_b128 v15, a[64:67] offset:0
    v_perm_b32 v127, v157, v153, s54
    v_mfma_f32_16x16x32_bf16 a[8:11], v[120:123], a[100:103], a[8:11]
    v_perm_b32 v112, v134, v130, s53
    v_mfma_f32_16x16x32_bf16 a[40:43], v[120:123], a[104:107], a[40:43]
    ds_write_b128 v13, a[4:7] offset:12288
    v_perm_b32 v113, v142, v138, s53
    v_mfma_f32_16x16x32_bf16 a[72:75], v[120:123], a[108:111], a[72:75]
    ds_write_b128 v14, a[36:39] offset:12288
    v_perm_b32 v114, v150, v146, s53
    v_mfma_f32_16x16x32_bf16 v[88:91], v[120:123], a[96:99], v[88:91]
    ds_write_b128 v15, a[68:71] offset:12288
    v_perm_b32 v115, v158, v154, s53
    v_mfma_f32_16x16x32_bf16 a[12:15], v[124:127], a[100:103], a[12:15]
    v_perm_b32 v116, v134, v130, s54
    v_mfma_f32_16x16x32_bf16 a[44:47], v[124:127], a[104:107], a[44:47]
    ds_write_b128 v13, a[8:11] offset:24576
    v_perm_b32 v117, v142, v138, s54
    v_mfma_f32_16x16x32_bf16 a[76:79], v[124:127], a[108:111], a[76:79]
    ds_write_b128 v14, a[40:43] offset:24576
    v_perm_b32 v118, v150, v146, s54
    v_mfma_f32_16x16x32_bf16 v[92:95], v[124:127], a[96:99], v[92:95]
    ds_write_b128 v15, a[72:75] offset:24576
    v_perm_b32 v119, v158, v154, s54
    v_mfma_f32_16x16x32_bf16 a[16:19], v[112:115], a[100:103], a[16:19]
    v_perm_b32 v120, v135, v131, s53
    v_mfma_f32_16x16x32_bf16 a[48:51], v[112:115], a[104:107], a[48:51]
    ds_write_b128 v13, a[12:15] offset:36864
    v_perm_b32 v121, v143, v139, s53
    v_mfma_f32_16x16x32_bf16 a[80:83], v[112:115], a[108:111], a[80:83]
    ds_write_b128 v14, a[44:47] offset:36864
    v_perm_b32 v122, v151, v147, s53
    v_mfma_f32_16x16x32_bf16 v[96:99], v[112:115], a[96:99], v[96:99]
    ds_write_b128 v15, a[76:79] offset:36864
    v_perm_b32 v123, v159, v155, s53
    s_waitcnt lgkmcnt(6)
    s_barrier
    ds_read_b128 v[224:227], v16 offset:0
    ds_read_b128 v[228:231], v16 offset:12288
    ds_read_b128 v[232:235], v16 offset:1024
    ds_read_b128 v[236:239], v16 offset:13312
    ds_read_b128 v[240:243], v16 offset:2048
    ds_read_b128 v[244:247], v16 offset:14336
    v_mfma_f32_16x16x32_bf16 a[20:23], v[116:119], a[100:103], a[20:23]
    v_perm_b32 v124, v135, v131, s54
    v_mfma_f32_16x16x32_bf16 a[52:55], v[116:119], a[104:107], a[52:55]
    ds_write_b128 v30, a[16:19] offset:0
    v_perm_b32 v125, v143, v139, s54
    v_mfma_f32_16x16x32_bf16 a[84:87], v[116:119], a[108:111], a[84:87]
    ds_write_b128 v31, a[48:51] offset:0
    v_perm_b32 v126, v151, v147, s54
    v_mfma_f32_16x16x32_bf16 v[100:103], v[116:119], a[96:99], v[100:103]
    ds_write_b128 v32, a[80:83] offset:0
    v_perm_b32 v127, v159, v155, s54
    v_mfma_f32_16x16x32_bf16 a[24:27], v[120:123], a[100:103], a[24:27]
    v_mfma_f32_16x16x32_bf16 a[56:59], v[120:123], a[104:107], a[56:59]
    ds_write_b128 v30, a[20:23] offset:12288
    v_mfma_f32_16x16x32_bf16 a[88:91], v[120:123], a[108:111], a[88:91]
    ds_write_b128 v31, a[52:55] offset:12288
    v_mfma_f32_16x16x32_bf16 v[104:107], v[120:123], a[96:99], v[104:107]
    ds_write_b128 v32, a[84:87] offset:12288
    s_waitcnt lgkmcnt(12)
    s_barrier
    ds_read_b128 v[128:131], v16 offset:24576
    ds_read_b128 v[132:135], v16 offset:36864
    ds_read_b128 v[136:139], v16 offset:25600
    ds_read_b128 v[140:143], v16 offset:37888
    ds_read_b128 v[144:147], v16 offset:26624
    ds_read_b128 v[148:151], v16 offset:38912
    s_waitcnt lgkmcnt(12)
    v_mfma_f32_16x16x32_bf16 a[28:31], v[124:127], a[100:103], a[28:31]
    v_pk_add_f32 v[80:81], v[80:81], v[224:225]
    v_pk_add_f32 v[82:83], v[82:83], v[226:227]
    v_pk_add_f32 v[84:85], v[84:85], v[228:229]
    v_pk_add_f32 v[86:87], v[86:87], v[230:231]
    v_pk_add_f32 v[80:81], v[80:81], v[232:233]
    v_pk_add_f32 v[82:83], v[82:83], v[234:235]
    v_mfma_f32_16x16x32_bf16 a[60:63], v[124:127], a[104:107], a[60:63]
    ds_write_b128 v30, a[24:27] offset:24576
    v_pk_add_f32 v[84:85], v[84:85], v[236:237]
    v_pk_add_f32 v[86:87], v[86:87], v[238:239]
    v_pk_add_f32 v[80:81], v[80:81], v[240:241]
    v_pk_add_f32 v[82:83], v[82:83], v[242:243]
    v_pk_add_f32 v[84:85], v[84:85], v[244:245]
    v_pk_add_f32 v[86:87], v[86:87], v[246:247]
    v_mfma_f32_16x16x32_bf16 a[92:95], v[124:127], a[108:111], a[92:95]
    ds_write_b128 v31, a[56:59] offset:24576
    v_cvt_pk_bf16_f32 v64, v80, v84
    v_cvt_pk_bf16_f32 v68, v81, v85
    v_cvt_pk_bf16_f32 v72, v82, v86
    v_cvt_pk_bf16_f32 v76, v83, v87
    v_pk_max_i16 v64, v64, 0
    v_pk_max_i16 v68, v68, 0
    v_mfma_f32_16x16x32_bf16 v[108:111], v[124:127], a[96:99], v[108:111]
    ds_write_b128 v32, a[88:91] offset:24576
    v_pk_max_i16 v72, v72, 0
    v_pk_max_i16 v76, v76, 0
    v_dot2_f32_bf16 v20, v64, v48, 0
    v_dot2_f32_bf16 v21, v68, v52, 0
    v_dot2_f32_bf16 v22, v72, v56, 0
    v_dot2_f32_bf16 v23, v76, v60, 0
    ds_write_b128 v30, a[28:31] offset:36864
    ds_write_b128 v31, a[60:63] offset:36864
    ds_write_b128 v32, a[92:95] offset:36864
    s_waitcnt lgkmcnt(12)
    s_barrier
    ds_read_b128 v[224:227], v33 offset:0
    ds_read_b128 v[228:231], v33 offset:12288
    ds_read_b128 v[232:235], v33 offset:1024
    ds_read_b128 v[236:239], v33 offset:13312
    ds_read_b128 v[240:243], v33 offset:2048
    ds_read_b128 v[244:247], v33 offset:14336
    s_waitcnt lgkmcnt(12)
    v_pk_add_f32 v[88:89], v[88:89], v[128:129]
    v_pk_add_f32 v[90:91], v[90:91], v[130:131]
    v_pk_add_f32 v[92:93], v[92:93], v[132:133]
    v_pk_add_f32 v[94:95], v[94:95], v[134:135]
    v_pk_add_f32 v[88:89], v[88:89], v[136:137]
    v_pk_add_f32 v[90:91], v[90:91], v[138:139]
    v_pk_add_f32 v[92:93], v[92:93], v[140:141]
    v_pk_add_f32 v[94:95], v[94:95], v[142:143]
    v_pk_add_f32 v[88:89], v[88:89], v[144:145]
    v_pk_add_f32 v[90:91], v[90:91], v[146:147]
    v_pk_add_f32 v[92:93], v[92:93], v[148:149]
    v_pk_add_f32 v[94:95], v[94:95], v[150:151]
    v_cvt_pk_bf16_f32 v65, v88, v92
    v_cvt_pk_bf16_f32 v69, v89, v93
    v_cvt_pk_bf16_f32 v73, v90, v94
    v_cvt_pk_bf16_f32 v77, v91, v95
    v_pk_max_i16 v65, v65, 0
    v_pk_max_i16 v69, v69, 0
    v_pk_max_i16 v73, v73, 0
    v_pk_max_i16 v77, v77, 0
    v_dot2_f32_bf16 v20, v65, v49, v20
    v_dot2_f32_bf16 v21, v69, v53, v21
    v_dot2_f32_bf16 v22, v73, v57, v22
    v_dot2_f32_bf16 v23, v77, v61, v23
    s_waitcnt lgkmcnt(6)
    s_barrier
    ds_read_b128 v[128:131], v33 offset:24576
    ds_read_b128 v[132:135], v33 offset:36864
    ds_read_b128 v[136:139], v33 offset:25600
    ds_read_b128 v[140:143], v33 offset:37888
    ds_read_b128 v[144:147], v33 offset:26624
    ds_read_b128 v[148:151], v33 offset:38912
    s_waitcnt lgkmcnt(6)
    v_pk_add_f32 v[96:97], v[96:97], v[224:225]
    v_pk_add_f32 v[98:99], v[98:99], v[226:227]
    v_pk_add_f32 v[100:101], v[100:101], v[228:229]
    v_pk_add_f32 v[102:103], v[102:103], v[230:231]
    v_pk_add_f32 v[96:97], v[96:97], v[232:233]
    v_pk_add_f32 v[98:99], v[98:99], v[234:235]
    v_pk_add_f32 v[100:101], v[100:101], v[236:237]
    v_pk_add_f32 v[102:103], v[102:103], v[238:239]
    v_pk_add_f32 v[96:97], v[96:97], v[240:241]
    v_pk_add_f32 v[98:99], v[98:99], v[242:243]
    v_pk_add_f32 v[100:101], v[100:101], v[244:245]
    v_pk_add_f32 v[102:103], v[102:103], v[246:247]
    v_cvt_pk_bf16_f32 v66, v96, v100
    v_cvt_pk_bf16_f32 v70, v97, v101
    v_cvt_pk_bf16_f32 v74, v98, v102
    v_cvt_pk_bf16_f32 v78, v99, v103
    v_pk_max_i16 v66, v66, 0
    v_pk_max_i16 v70, v70, 0
    v_pk_max_i16 v74, v74, 0
    v_pk_max_i16 v78, v78, 0
    v_dot2_f32_bf16 v20, v66, v50, v20
    v_dot2_f32_bf16 v21, v70, v54, v21
    v_dot2_f32_bf16 v22, v74, v58, v22
    v_dot2_f32_bf16 v23, v78, v62, v23
    s_waitcnt lgkmcnt(4)
    v_pk_add_f32 v[104:105], v[104:105], v[128:129]
    v_pk_add_f32 v[106:107], v[106:107], v[130:131]
    v_pk_add_f32 v[108:109], v[108:109], v[132:133]
    v_pk_add_f32 v[110:111], v[110:111], v[134:135]
    s_waitcnt lgkmcnt(2)
    v_pk_add_f32 v[104:105], v[104:105], v[136:137]
    v_pk_add_f32 v[106:107], v[106:107], v[138:139]
    v_pk_add_f32 v[108:109], v[108:109], v[140:141]
    v_pk_add_f32 v[110:111], v[110:111], v[142:143]
    s_waitcnt lgkmcnt(0)
    v_pk_add_f32 v[104:105], v[104:105], v[144:145]
    v_pk_add_f32 v[106:107], v[106:107], v[146:147]
    v_pk_add_f32 v[108:109], v[108:109], v[148:149]
    v_pk_add_f32 v[110:111], v[110:111], v[150:151]
    v_cvt_pk_bf16_f32 v67, v104, v108
    v_cvt_pk_bf16_f32 v71, v105, v109
    v_cvt_pk_bf16_f32 v75, v106, v110
    v_cvt_pk_bf16_f32 v79, v107, v111
    v_pk_max_i16 v67, v67, 0
    v_pk_max_i16 v71, v71, 0
    v_pk_max_i16 v75, v75, 0
    v_pk_max_i16 v79, v79, 0
    v_dot2_f32_bf16 v20, v67, v51, v20
    v_dot2_f32_bf16 v21, v71, v55, v21
    v_dot2_f32_bf16 v22, v75, v59, v22
    v_dot2_f32_bf16 v23, v79, v63, v23
    s_nop 2
    v_add_f32 v20, v20, v21
    v_add_f32 v22, v22, v23
    v_add_f32 v20, v20, v22
    v_mov_b32 v21, v20
    s_nop 1
    v_permlane32_swap_b32 v20, v21
    v_add_f32 v20, v20, v21
    v_mov_b32 v21, v20
    s_nop 1
    v_permlane16_swap_b32 v20, v21
    v_add_f32 v20, v20, v21
    v_cvt_pk_bf16_f32 v20, 0, v20
    v_add_f32 v20, s73, v20
    v_cvt_pk_bf16_f32 v20, 0, v20
    v_add_f32 v20, v12, v20
    v_cvt_pk_bf16_f32 v20, 0, v20
    v_mul_f32 v20, 0xbfb8aa3b, v20
    v_exp_f32 v20, v20
    s_mov_b32 exec_lo, 0xffff
    v_add_f32 v20, 1.0, v20
    v_rcp_f32 v20, v20
    s_mov_b32 exec_hi, 0
    v_cvt_pk_bf16_f32 v20, v20, v20
    buffer_store_short v20, v18, s[48:51], s62 offen
L_end:
    s_endpgm
.section .rodata,"a"
.p2align 6
.amdhsa_kernel standalone__deep_cross_wide_deep__recsys_kernel
  .amdhsa_next_free_vgpr 512
  .amdhsa_next_free_sgpr 102
  .amdhsa_accum_offset 256
  .amdhsa_group_segment_fixed_size 0
  .amdhsa_kernarg_size 96
  .amdhsa_user_sgpr_count 2
  .amdhsa_user_sgpr_kernarg_segment_ptr 1
  .amdhsa_system_sgpr_workgroup_id_x 1
.end_amdhsa_kernel
```
